```python
import torch

def _softmax(x, axis=-1):
    return torch.softmax(x, dim=axis)
def _gelu(x):
    return torch.nn.functional.gelu(x, approximate="tanh")
def _silu(x):
    return torch.nn.functional.silu(x)
def _sigmoid(x):
    return torch.sigmoid(x)
def _layernorm(x, axis=-1, eps=1e-5):
    m = x.mean(dim=axis, keepdim=True)
    v = x.var(dim=axis, keepdim=True, unbiased=False)
    return (x - m) / torch.sqrt(v + eps)
def _scatter_add(tgt, idx, src, axis=0):
    return tgt.clone().index_add_(axis, idx, src)
def _segment_sum(src, seg, n):
    out = torch.zeros((n,) + src.shape[1:], dtype=src.dtype)
    return out.index_add_(0, seg, src)
def _pad(x, pw):
    flat = tuple(v for pair in reversed(pw) for v in pair)
    return torch.nn.functional.pad(x, flat)

kernel_name = 'recurrent_scan__sliding_block_cached__geglu_ffn__decode'

def setup_inputs():

    _w = (lambda a: (lambda t: t.to(torch.bfloat16) if t.is_floating_point() else t)(torch.as_tensor(a)))
    def _A_setup():
        B, Sq, D = 1, 1, 640
        Hq, Hkv, Sk, Dh = 32, 32, 32768, 192
        assert Hq % Hkv == 0, (Hq, Hkv)
        return {
            "x": _w((lambda *s: torch.randn(*s, dtype=torch.bfloat16) * 0.05)(B, Sq, D)),
            "k_cache": _w((lambda *s: torch.randn(*s, dtype=torch.bfloat16) * 1.6)(B, Hkv, Sk, Dh)),
            "v_cache": _w((lambda *s: torch.randn(*s, dtype=torch.bfloat16) * 0.2)(B, Hkv, Sk, Dh)),
            "wq": _w((lambda *s: torch.randn(*s, dtype=torch.bfloat16) * 1.6)(D, Hq * Dh) * (D ** -0.5)),
            "wo": _w((lambda *s: torch.randn(*s, dtype=torch.bfloat16) * 0.2)(Hq * Dh, D) * ((Hq * Dh) ** -0.5)),
        }
    _A_in = _A_setup()

    def _B_setup():
        B, S, D, F = 1, 1, 640, 1536
        return {
            "x": _w((lambda *s: torch.randn(*s, dtype=torch.bfloat16) * 0.05)(B, S, D)),
            "w_gate": _w((lambda *s: torch.randn(*s, dtype=torch.bfloat16) * 0.1)(D, F)),
            "w_up": _w((lambda *s: torch.randn(*s, dtype=torch.bfloat16) * 0.1)(D, F)),
            "w_down": _w((lambda *s: torch.randn(*s, dtype=torch.bfloat16) * 0.1)(F, D)),
        }
    _B_in = _B_setup()

    return {
        "A_x": _A_in["x"],
        "A_k_cache": _A_in["k_cache"],
        "A_v_cache": _A_in["v_cache"],
        "A_wq": _A_in["wq"],
        "A_wo": _A_in["wo"],
        "B_x": _B_in["x"],
        "B_w_gate": _B_in["w_gate"],
        "B_w_up": _B_in["w_up"],
        "B_w_down": _B_in["w_down"],
    }

def reference(A_x, A_k_cache, A_v_cache, A_wq, A_wo, B_x, B_w_gate, B_w_up, B_w_down):
    def _A_ref(x, k_cache, v_cache, wq, wo):
        B, Sq, D = x.shape
        Hq, Dh = 32, 192
        Hkv, Sk = k_cache.shape[1], k_cache.shape[2]
        W = min(4096, max(256, Sk // 4))
        rep = Hq // Hkv
        q = (lambda x, *d: x.permute(*d))((x @ wq).reshape(B, Sq, Hq, Dh), 0, 2, 1, 3)
        k = (lambda x, n, axis: torch.repeat_interleave(x, n, dim=axis))(k_cache[:, :, Sk - W:, :], rep, axis=1)
        v = (lambda x, n, axis: torch.repeat_interleave(x, n, dim=axis))(v_cache[:, :, Sk - W:, :], rep, axis=1)
        scores = torch.einsum("bhqd,bhkd->bhqk", q, k) * (Dh ** -0.5)
        p = _softmax(scores, axis=-1)
        o = torch.einsum("bhqk,bhkd->bhqd", p, v)
        return (lambda x, *d: x.permute(*d))(o, 0, 2, 1, 3).reshape(B, Sq, Hq * Dh) @ wo

    def _B_ref(x, w_gate, w_up, w_down):
        return (_gelu(x @ w_gate) * (x @ w_up)) @ w_down

    x = A_x
    xn = _layernorm(x, axis=-1)
    s = _A_ref(xn, A_k_cache, A_v_cache, A_wq, A_wo)
    g = _silu(_B_ref(xn, B_w_gate, B_w_up, B_w_down))
    return x + s * g
```

```asm
; @launch grid=(256,1,1) block=(512,1,1) lds=37888
.amdgcn_target "amdgcn-amd-amdhsa--gfx950"
.text
.globl recurrent_scan__sliding_block_cached__geglu_ffn__decode_kernel
.p2align 8
.type recurrent_scan__sliding_block_cached__geglu_ffn__decode_kernel,@function
recurrent_scan__sliding_block_cached__geglu_ffn__decode_kernel:
    s_cmp_ge_u32 s2, 256
    s_cbranch_scc1 L_end

    s_load_dwordx16 s[8:23], s[0:1], 0
    s_load_dwordx8 s[24:31], s[0:1], 64
    s_getreg_b32 s77, hwreg(HW_REG_XCC_ID)
    s_getpc_b64 s[52:53]
L_pc:
    v_lshlrev_b32 v3, 4, v0
    v_min_u32 v4, L_end-L_pc-12, v3
    global_load_dwordx4 v[208:211], v4, s[52:53]
    v_add_u32 v3, 8192, v3
    v_min_u32 v4, L_end-L_pc-12, v3
    global_load_dwordx4 v[212:215], v4, s[52:53]
    v_add_u32 v3, 8192, v3
    v_min_u32 v4, L_end-L_pc-12, v3
    global_load_dwordx4 v[216:219], v4, s[52:53]
    v_and_b32 v1, 63, v0
    v_lshrrev_b32 v2, 6, v0
    s_and_b32 s5, s2, 7
    s_lshl_b32 s5, s5, 2
    s_lshr_b32 s3, s2, 3
    s_and_b32 s3, s3, 3
    v_readfirstlane_b32 s4, v2
    s_add_u32 s5, s5, s3
    s_lshr_b32 s6, s2, 5
    s_lshl_b32 s7, s5, 3
    s_add_u32 s7, s7, s6
    s_mul_i32 s61, s6, 80
    s_mul_i32 s62, s4, 10
    s_add_u32 s61, s61, s62
    s_mul_i32 s62, s61, 12288
    s_mul_i32 s63, s5, 384
    s_add_u32 s62, s62, s63
    s_mul_i32 s63, s61, 3072
    s_mul_i32 s3, s5, 96
    s_add_u32 s63, s63, s3
    v_mul_u32_u24 v3, 20, v1
    v_cmp_gt_u32 vcc, 32, v1
    v_and_b32 v4, 7, v1
    v_mov_b32 v6, 3072
    v_mov_b32 v7, 12288
    v_cndmask_b32 v4, v4, v1, vcc
    v_mul_u32_u24 v4, 12, v4
    v_cndmask_b32 v6, v6, v7, vcc
    v_mov_b32 v7, 0
    v_cmp_gt_u32 s[90:91], 40, v1
    s_waitcnt lgkmcnt(0)

    s_load_dwordx2 s[48:49], s[30:31], 0

    s_mul_i32 s52, s5, 12582912
    s_lshl_b32 s53, s6, 9
    s_lshl_b32 s54, s4, 6
    s_add_u32 s53, s53, s54
    s_add_u32 s53, s53, 28672
    s_mul_i32 s53, s53, 384
    s_add_u32 s52, s52, s53
    s_add_u32 s32, s10, s52
    s_addc_u32 s33, s11, 0
    s_mov_b32 s34, 24576
    s_mov_b32 s35, 0x20000
    s_add_u32 s36, s12, s52
    s_addc_u32 s37, s13, 0
    s_mov_b32 s38, 24576
    s_mov_b32 s39, 0x20000
    v_lshrrev_b32 v10, 3, v1
    v_mul_u32_u24 v10, 384, v10
    v_and_b32 v11, 7, v1
    v_lshl_add_u32 v252, v11, 4, v10
    v_lshrrev_b32 v10, 4, v1
    v_and_b32 v12, 15, v1
    v_mul_u32_u24 v253, 768, v10
    v_lshl_add_u32 v253, v12, 4, v253
    v_mul_u32_u24 v254, 1280, v10
    v_lshl_add_u32 v254, v12, 4, v254
    v_and_b32 v10, 1, v10
    v_mul_u32_u24 v255, 1280, v10
    v_lshl_add_u32 v255, v12, 4, v255

    global_load_dwordx4 v[144:147], v3, s[8:9]
    global_load_dword v148, v3, s[8:9] offset:16
    v_min_u32 v10, 9, v1
    v_add_u32 v10, s61, v10
    v_lshlrev_b32 v10, 1, v10
    global_load_ushort v149, v10, s[8:9]
    s_add_u32 s14, s14, s62
    s_addc_u32 s15, s15, 0
    s_add_u32 s20, s20, s63
    s_addc_u32 s21, s21, 0
    s_add_u32 s22, s22, s63
    s_addc_u32 s23, s23, 0
    v_mov_b32 v8, s22
    v_mov_b32 v9, s23
    v_mov_b32 v10, s20
    v_mov_b32 v11, s21
    v_cndmask_b32 v8, v8, v10, s[90:91]
    v_cndmask_b32 v9, v9, v11, s[90:91]
    v_mov_b32 v10, s14
    v_mov_b32 v11, s15
    v_cndmask_b32 v8, v8, v10, vcc
    v_cndmask_b32 v9, v9, v11, vcc
    v_add_co_u32 v8, vcc, v8, v4
    s_nop 1
    v_addc_co_u32 v9, vcc, 0, v9, vcc

    s_mov_b32 exec_lo, 0xffffffff
    s_mov_b32 exec_hi, 0xffff
    global_load_dwordx3 v[152:154], v[8:9], off nt
    v_lshl_add_u64 v[8:9], v[6:7], 0, v[8:9]
    global_load_dwordx3 v[156:158], v[8:9], off nt
    v_lshl_add_u64 v[8:9], v[6:7], 0, v[8:9]
    global_load_dwordx3 v[160:162], v[8:9], off nt
    v_lshl_add_u64 v[8:9], v[6:7], 0, v[8:9]
    global_load_dwordx3 v[164:166], v[8:9], off nt
    v_lshl_add_u64 v[8:9], v[6:7], 0, v[8:9]
    global_load_dwordx3 v[168:170], v[8:9], off nt
    v_lshl_add_u64 v[8:9], v[6:7], 0, v[8:9]
    global_load_dwordx3 v[172:174], v[8:9], off nt
    v_lshl_add_u64 v[8:9], v[6:7], 0, v[8:9]
    global_load_dwordx3 v[176:178], v[8:9], off nt
    v_lshl_add_u64 v[8:9], v[6:7], 0, v[8:9]
    global_load_dwordx3 v[180:182], v[8:9], off nt
    v_lshl_add_u64 v[8:9], v[6:7], 0, v[8:9]
    global_load_dwordx3 v[184:186], v[8:9], off nt
    v_lshl_add_u64 v[8:9], v[6:7], 0, v[8:9]
    global_load_dwordx3 v[188:190], v[8:9], off nt
    s_mov_b64 exec, -1
    s_mul_i32 s3, s5, 38912
    s_add_u32 s3, s3, 4096
    s_add_u32 s64, s30, s3
    s_addc_u32 s65, s31, 0
    s_mov_b32 s66, 38912
    s_mov_b32 s67, 0x20000
    s_mul_i32 s3, s5, 12288
    s_add_u32 s3, s3, 1310720
    s_add_u32 s68, s30, s3
    s_addc_u32 s69, s31, 0
    s_mov_b32 s70, 12288
    s_mov_b32 s71, 0x20000
    s_add_u32 s72, s30, 1703936
    s_addc_u32 s73, s31, 0
    s_mov_b32 s74, 327680
    s_mov_b32 s75, 0x20000
    s_mul_i32 s3, s5, 1024
    s_add_u32 s3, s3, 2031616
    s_add_u32 s56, s30, s3
    s_addc_u32 s57, s31, 0
    s_mov_b32 s58, 1024
    s_mov_b32 s59, 0x20000
    s_mul_i32 s3, s5, 245760
    s_mul_i32 s61, s4, 30720
    s_add_u32 s3, s3, s61
    s_mul_i32 s62, s6, 160
    s_add_u32 s3, s3, s62
    s_add_u32 s40, s16, s3
    s_addc_u32 s41, s17, 0
    s_mov_b32 s42, 29600
    s_mov_b32 s43, 0x20000
    s_mul_i32 s3, s5, 61440
    s_mul_i32 s61, s4, 7680
    s_add_u32 s3, s3, s61
    s_add_u32 s3, s3, s62
    s_add_u32 s44, s24, s3
    s_addc_u32 s45, s25, 0
    s_mov_b32 s46, 6560
    s_mov_b32 s47, 0x20000

    s_barrier
    s_mov_b32 s60, 0
    buffer_load_dwordx4 v[16:19], v252, s[32:35], s60 offen offset:0 nt
    s_mov_b32 s60, 0
    buffer_load_dwordx4 v[20:23], v252, s[32:35], s60 offen offset:128 nt
    s_mov_b32 s60, 0
    buffer_load_dwordx4 v[24:27], v252, s[32:35], s60 offen offset:256 nt
    s_mov_b32 s60, 3072
    buffer_load_dwordx4 v[28:31], v252, s[32:35], s60 offen offset:0 nt
    s_mov_b32 s60, 3072
    buffer_load_dwordx4 v[32:35], v252, s[32:35], s60 offen offset:128 nt
    s_waitcnt vmcnt(15)
    v_lshlrev_b32 v112, 16, v144
    v_and_b32 v113, 0xffff0000, v144
    v_lshlrev_b32 v114, 16, v145
    v_and_b32 v115, 0xffff0000, v145
    v_lshlrev_b32 v116, 16, v146
    v_and_b32 v117, 0xffff0000, v146
    v_lshlrev_b32 v118, 16, v147
    v_and_b32 v119, 0xffff0000, v147
    v_lshlrev_b32 v120, 16, v148
    v_and_b32 v121, 0xffff0000, v148
    v_add_f32 v2, v112, v113
    v_add_f32 v2, v2, v114
    v_add_f32 v2, v2, v115
    v_add_f32 v2, v2, v116
    v_add_f32 v2, v2, v117
    v_add_f32 v2, v2, v118
    v_add_f32 v2, v2, v119
    v_add_f32 v2, v2, v120
    v_add_f32 v2, v2, v121
    s_nop 1
    v_add_f32_dpp v2, v2, v2 quad_perm:[1,0,3,2] row_mask:0xf bank_mask:0xf
    s_nop 1
    v_add_f32_dpp v2, v2, v2 quad_perm:[2,3,0,1] row_mask:0xf bank_mask:0xf
    s_nop 1
    v_add_f32_dpp v2, v2, v2 row_half_mirror row_mask:0xf bank_mask:0xf
    s_nop 1
    v_add_f32_dpp v2, v2, v2 row_mirror row_mask:0xf bank_mask:0xf
    s_nop 1
    v_readlane_b32 s84, v2, 0
    v_readlane_b32 s85, v2, 16
    v_readlane_b32 s86, v2, 32
    v_readlane_b32 s87, v2, 48
    s_nop 1
    v_mov_b32 v2, s84
    v_add_f32 v2, s85, v2
    v_add_f32 v2, s86, v2
    v_add_f32 v2, s87, v2
    v_mul_f32 v2, 0x3acccccd, v2
    v_sub_f32 v3, v112, v2
    v_mul_f32 v4, v3, v3
    v_sub_f32 v3, v113, v2
    v_fmac_f32 v4, v3, v3
    v_sub_f32 v3, v114, v2
    v_fmac_f32 v4, v3, v3
    v_sub_f32 v3, v115, v2
    v_fmac_f32 v4, v3, v3
    v_sub_f32 v3, v116, v2
    v_fmac_f32 v4, v3, v3
    v_sub_f32 v3, v117, v2
    v_fmac_f32 v4, v3, v3
    v_sub_f32 v3, v118, v2
    v_fmac_f32 v4, v3, v3
    v_sub_f32 v3, v119, v2
    v_fmac_f32 v4, v3, v3
    v_sub_f32 v3, v120, v2
    v_fmac_f32 v4, v3, v3
    v_sub_f32 v3, v121, v2
    v_fmac_f32 v4, v3, v3
    s_nop 1
    v_add_f32_dpp v4, v4, v4 quad_perm:[1,0,3,2] row_mask:0xf bank_mask:0xf
    s_nop 1
    v_add_f32_dpp v4, v4, v4 quad_perm:[2,3,0,1] row_mask:0xf bank_mask:0xf
    s_nop 1
    v_add_f32_dpp v4, v4, v4 row_half_mirror row_mask:0xf bank_mask:0xf
    s_nop 1
    v_add_f32_dpp v4, v4, v4 row_mirror row_mask:0xf bank_mask:0xf
    s_nop 1
    v_readlane_b32 s84, v4, 0
    v_readlane_b32 s85, v4, 16
    v_readlane_b32 s86, v4, 32
    v_readlane_b32 s87, v4, 48
    s_nop 1
    v_mov_b32 v4, s84
    v_add_f32 v4, s85, v4
    v_add_f32 v4, s86, v4
    v_add_f32 v4, s87, v4
    v_mul_f32 v4, 0x3acccccd, v4
    v_cvt_pk_bf16_f32 v2, v2, v2
    v_lshlrev_b32 v2, 16, v2
    v_cvt_pk_bf16_f32 v4, v4, v4
    v_lshlrev_b32 v4, 16, v4
    v_add_f32 v4, 0x3727c5ac, v4
    v_cvt_pk_bf16_f32 v4, v4, v4
    v_lshlrev_b32 v4, 16, v4
    v_sqrt_f32 v4, v4
    s_nop 0
    v_cvt_pk_bf16_f32 v4, v4, v4
    v_lshlrev_b32 v4, 16, v4
    v_rcp_f32 v5, v4
    v_lshlrev_b32 v3, 16, v149
    v_sub_f32 v3, v3, v2
    v_cvt_pk_bf16_f32 v3, v3, v3
    v_lshlrev_b32 v3, 16, v3
    v_mul_f32 v6, v3, v5
    v_fma_f32 v7, -v6, v4, v3
    v_fmac_f32 v6, v7, v5
    v_cvt_pk_bf16_f32 v6, v6, v6
    v_lshlrev_b32 v6, 16, v6
    s_nop 0
    v_readlane_b32 s80, v6, 0
    v_readlane_b32 s81, v6, 1
    v_readlane_b32 s82, v6, 2
    v_readlane_b32 s83, v6, 3
    v_readlane_b32 s84, v6, 4
    v_readlane_b32 s85, v6, 5
    v_readlane_b32 s86, v6, 6
    v_readlane_b32 s87, v6, 7
    v_readlane_b32 s88, v6, 8
    v_readlane_b32 s89, v6, 9
    s_waitcnt vmcnt(5)
    v_mov_b32 v122, 0
    v_mov_b32 v123, 0
    v_mov_b32 v124, 0
    v_mov_b32 v125, 0
    v_mov_b32 v126, 0
    v_mov_b32 v127, 0
    v_lshlrev_b32 v2, 16, v152
    v_and_b32 v3, 0xffff0000, v152
    v_fmac_f32 v122, s80, v2
    v_fmac_f32 v123, s80, v3
    v_lshlrev_b32 v2, 16, v153
    v_and_b32 v3, 0xffff0000, v153
    v_fmac_f32 v124, s80, v2
    v_fmac_f32 v125, s80, v3
    v_lshlrev_b32 v2, 16, v154
    v_and_b32 v3, 0xffff0000, v154
    v_fmac_f32 v126, s80, v2
    v_fmac_f32 v127, s80, v3
    v_lshlrev_b32 v2, 16, v156
    v_and_b32 v3, 0xffff0000, v156
    v_fmac_f32 v122, s81, v2
    v_fmac_f32 v123, s81, v3
    v_lshlrev_b32 v2, 16, v157
    v_and_b32 v3, 0xffff0000, v157
    v_fmac_f32 v124, s81, v2
    v_fmac_f32 v125, s81, v3
    v_lshlrev_b32 v2, 16, v158
    v_and_b32 v3, 0xffff0000, v158
    v_fmac_f32 v126, s81, v2
    v_fmac_f32 v127, s81, v3
    v_lshlrev_b32 v2, 16, v160
    v_and_b32 v3, 0xffff0000, v160
    v_fmac_f32 v122, s82, v2
    v_fmac_f32 v123, s82, v3
    v_lshlrev_b32 v2, 16, v161
    v_and_b32 v3, 0xffff0000, v161
    v_fmac_f32 v124, s82, v2
    v_fmac_f32 v125, s82, v3
    v_lshlrev_b32 v2, 16, v162
    v_and_b32 v3, 0xffff0000, v162
    v_fmac_f32 v126, s82, v2
    v_fmac_f32 v127, s82, v3
    v_lshlrev_b32 v2, 16, v164
    v_and_b32 v3, 0xffff0000, v164
    v_fmac_f32 v122, s83, v2
    v_fmac_f32 v123, s83, v3
    v_lshlrev_b32 v2, 16, v165
    v_and_b32 v3, 0xffff0000, v165
    v_fmac_f32 v124, s83, v2
    v_fmac_f32 v125, s83, v3
    v_lshlrev_b32 v2, 16, v166
    v_and_b32 v3, 0xffff0000, v166
    v_fmac_f32 v126, s83, v2
    v_fmac_f32 v127, s83, v3
    v_lshlrev_b32 v2, 16, v168
    v_and_b32 v3, 0xffff0000, v168
    v_fmac_f32 v122, s84, v2
    v_fmac_f32 v123, s84, v3
    v_lshlrev_b32 v2, 16, v169
    v_and_b32 v3, 0xffff0000, v169
    v_fmac_f32 v124, s84, v2
    v_fmac_f32 v125, s84, v3
    v_lshlrev_b32 v2, 16, v170
    v_and_b32 v3, 0xffff0000, v170
    v_fmac_f32 v126, s84, v2
    v_fmac_f32 v127, s84, v3
    v_lshlrev_b32 v2, 16, v172
    v_and_b32 v3, 0xffff0000, v172
    v_fmac_f32 v122, s85, v2
    v_fmac_f32 v123, s85, v3
    v_lshlrev_b32 v2, 16, v173
    v_and_b32 v3, 0xffff0000, v173
    v_fmac_f32 v124, s85, v2
    v_fmac_f32 v125, s85, v3
    v_lshlrev_b32 v2, 16, v174
    v_and_b32 v3, 0xffff0000, v174
    v_fmac_f32 v126, s85, v2
    v_fmac_f32 v127, s85, v3
    v_lshlrev_b32 v2, 16, v176
    v_and_b32 v3, 0xffff0000, v176
    v_fmac_f32 v122, s86, v2
    v_fmac_f32 v123, s86, v3
    v_lshlrev_b32 v2, 16, v177
    v_and_b32 v3, 0xffff0000, v177
    v_fmac_f32 v124, s86, v2
    v_fmac_f32 v125, s86, v3
    v_lshlrev_b32 v2, 16, v178
    v_and_b32 v3, 0xffff0000, v178
    v_fmac_f32 v126, s86, v2
    v_fmac_f32 v127, s86, v3
    v_lshlrev_b32 v2, 16, v180
    v_and_b32 v3, 0xffff0000, v180
    v_fmac_f32 v122, s87, v2
    v_fmac_f32 v123, s87, v3
    v_lshlrev_b32 v2, 16, v181
    v_and_b32 v3, 0xffff0000, v181
    v_fmac_f32 v124, s87, v2
    v_fmac_f32 v125, s87, v3
    v_lshlrev_b32 v2, 16, v182
    v_and_b32 v3, 0xffff0000, v182
    v_fmac_f32 v126, s87, v2
    v_fmac_f32 v127, s87, v3
    v_lshlrev_b32 v2, 16, v184
    v_and_b32 v3, 0xffff0000, v184
    v_fmac_f32 v122, s88, v2
    v_fmac_f32 v123, s88, v3
    v_lshlrev_b32 v2, 16, v185
    v_and_b32 v3, 0xffff0000, v185
    v_fmac_f32 v124, s88, v2
    v_fmac_f32 v125, s88, v3
    v_lshlrev_b32 v2, 16, v186
    v_and_b32 v3, 0xffff0000, v186
    v_fmac_f32 v126, s88, v2
    v_fmac_f32 v127, s88, v3
    v_lshlrev_b32 v2, 16, v188
    v_and_b32 v3, 0xffff0000, v188
    v_fmac_f32 v122, s89, v2
    v_fmac_f32 v123, s89, v3
    v_lshlrev_b32 v2, 16, v189
    v_and_b32 v3, 0xffff0000, v189
    v_fmac_f32 v124, s89, v2
    v_fmac_f32 v125, s89, v3
    v_lshlrev_b32 v2, 16, v190
    v_and_b32 v3, 0xffff0000, v190
    v_fmac_f32 v126, s89, v2
    v_fmac_f32 v127, s89, v3
    s_mul_i32 s3, s4, 1152
    v_mul_u32_u24 v2, 24, v1
    v_add_u32 v2, s3, v2

    s_mov_b32 exec_lo, 0xffffffff
    s_mov_b32 exec_hi, 0xffff
    ds_write_b64 v2, v[122:123] offset:0
    ds_write_b64 v2, v[124:125] offset:8
    ds_write_b64 v2, v[126:127] offset:16
    s_mov_b64 exec, -1
    s_waitcnt lgkmcnt(0)

    s_barrier
    s_add_u32 s48, s48, 1
    s_addc_u32 s49, s49, 0
    s_mul_i32 s50, s48, 0x9E3779B1
    s_xor_b32 s50, s50, 0x5bd1e995
    s_mul_i32 s51, s48, 0x85EBCA6B
    s_xor_b32 s51, s51, s49
    s_xor_b32 s51, s51, 0xc2b2ae35

    s_cmp_gt_u32 s4, 2
    s_cbranch_scc1 L_pub_skip
    v_min_u32 v8, 47, v1
    s_cmp_eq_u32 s4, 2
    s_cbranch_scc1 L_pub_h
    s_mul_i32 s3, s4, 384
    v_lshlrev_b32 v8, 3, v8
    v_add_u32 v8, s3, v8
    v_add_u32 v9, 4, v8
    s_branch L_pub_rd
L_pub_h:
    v_lshlrev_b32 v8, 2, v8
    v_add_u32 v9, 960, v8
    v_add_u32 v8, 768, v8
L_pub_rd:

    ds_read_b32 v208, v8 offset:0
    ds_read_b32 v209, v9 offset:0
    ds_read_b32 v210, v8 offset:1152
    ds_read_b32 v211, v9 offset:1152
    ds_read_b32 v212, v8 offset:2304
    ds_read_b32 v213, v9 offset:2304
    ds_read_b32 v214, v8 offset:3456
    ds_read_b32 v215, v9 offset:3456
    ds_read_b32 v216, v8 offset:4608
    ds_read_b32 v217, v9 offset:4608
    ds_read_b32 v218, v8 offset:5760
    ds_read_b32 v219, v9 offset:5760
    ds_read_b32 v220, v8 offset:6912
    ds_read_b32 v221, v9 offset:6912
    ds_read_b32 v222, v8 offset:8064
    ds_read_b32 v223, v9 offset:8064
    v_lshlrev_b32 v10, 4, v1
    s_mul_i32 s60, s6, 2432
    s_mul_i32 s3, s4, 768
    s_add_u32 s60, s60, s3
    s_add_u32 s61, s60, 19456
    v_mov_b32 v6, s50
    v_mov_b32 v7, s51
    s_mov_b32 exec_lo, -1
    s_cmp_eq_u32 s4, 2
    s_mov_b32 s3, 0xffff
    s_cselect_b32 s3, 0x1ffff, s3
    s_waitcnt lgkmcnt(8)
    v_add_f32 v4, v208, v210
    v_add_f32 v5, v209, v211
    v_add_f32 v4, v4, v212
    v_add_f32 v5, v5, v213
    v_add_f32 v4, v4, v214
    v_add_f32 v5, v5, v215
    s_waitcnt lgkmcnt(0)

    v_add_f32 v4, v4, v216
    v_add_f32 v5, v5, v217
    v_add_f32 v4, v4, v218
    v_add_f32 v5, v5, v219
    v_add_f32 v4, v4, v220
    v_add_f32 v5, v5, v221
    v_add_f32 v4, v4, v222
    v_add_f32 v5, v5, v223
    v_writelane_b32 v4, s77, 48
    s_mov_b32 exec_hi, s3
    buffer_store_dwordx4 v[4:7], v10, s[64:67], s60 offen
    buffer_store_dwordx4 v[4:7], v10, s[64:67], s61 offen sc1
    s_mov_b64 exec, -1

    s_mov_b32 s60, 3072
    buffer_load_dwordx4 v[36:39], v252, s[32:35], s60 offen offset:256 nt
    s_mov_b32 s60, 6144
    buffer_load_dwordx4 v[40:43], v252, s[32:35], s60 offen offset:0 nt
    s_mov_b32 s60, 6144
    buffer_load_dwordx4 v[44:47], v252, s[32:35], s60 offen offset:128 nt
    s_waitcnt vmcnt(9)
    s_mov_b32 s60, 6144
    buffer_load_dwordx4 v[48:51], v252, s[32:35], s60 offen offset:256 nt
    s_waitcnt vmcnt(9)
    s_mov_b32 s60, 9216
    buffer_load_dwordx4 v[52:55], v252, s[32:35], s60 offen offset:0 nt
    s_waitcnt vmcnt(9)
    s_mov_b32 s60, 9216
    buffer_load_dwordx4 v[56:59], v252, s[32:35], s60 offen offset:128 nt
    s_waitcnt vmcnt(9)
    s_mov_b32 s60, 9216
    buffer_load_dwordx4 v[60:63], v252, s[32:35], s60 offen offset:256 nt
    s_waitcnt vmcnt(9)
    s_mov_b32 s60, 12288
    buffer_load_dwordx4 v[64:67], v252, s[32:35], s60 offen offset:0 nt
    s_waitcnt vmcnt(9)
    s_mov_b32 s60, 12288
    buffer_load_dwordx4 v[68:71], v252, s[32:35], s60 offen offset:128 nt
    s_waitcnt vmcnt(9)
    s_mov_b32 s60, 12288
    buffer_load_dwordx4 v[72:75], v252, s[32:35], s60 offen offset:256 nt
    s_waitcnt vmcnt(9)
    s_mov_b32 s60, 15360
    buffer_load_dwordx4 v[76:79], v252, s[32:35], s60 offen offset:0 nt
    s_waitcnt vmcnt(9)
    s_mov_b32 s60, 15360
    buffer_load_dwordx4 v[80:83], v252, s[32:35], s60 offen offset:128 nt
    s_branch L_p1_join
L_pub_skip:
    s_waitcnt vmcnt(4)
    s_mov_b32 s60, 3072
    buffer_load_dwordx4 v[36:39], v252, s[32:35], s60 offen offset:256 nt
    s_waitcnt vmcnt(4)
    s_mov_b32 s60, 6144
    buffer_load_dwordx4 v[40:43], v252, s[32:35], s60 offen offset:0 nt
    s_waitcnt vmcnt(4)
    s_mov_b32 s60, 6144
    buffer_load_dwordx4 v[44:47], v252, s[32:35], s60 offen offset:128 nt
    s_waitcnt vmcnt(4)
    s_mov_b32 s60, 6144
    buffer_load_dwordx4 v[48:51], v252, s[32:35], s60 offen offset:256 nt
    s_waitcnt vmcnt(4)
    s_mov_b32 s60, 9216
    buffer_load_dwordx4 v[52:55], v252, s[32:35], s60 offen offset:0 nt
    s_waitcnt vmcnt(4)
    s_mov_b32 s60, 9216
    buffer_load_dwordx4 v[56:59], v252, s[32:35], s60 offen offset:128 nt
    s_waitcnt vmcnt(4)
    s_mov_b32 s60, 9216
    buffer_load_dwordx4 v[60:63], v252, s[32:35], s60 offen offset:256 nt
    s_waitcnt vmcnt(4)
    s_mov_b32 s60, 12288
    buffer_load_dwordx4 v[64:67], v252, s[32:35], s60 offen offset:0 nt
    s_waitcnt vmcnt(4)
    s_mov_b32 s60, 12288
    buffer_load_dwordx4 v[68:71], v252, s[32:35], s60 offen offset:128 nt
    s_waitcnt vmcnt(4)
    s_mov_b32 s60, 12288
    buffer_load_dwordx4 v[72:75], v252, s[32:35], s60 offen offset:256 nt
    s_waitcnt vmcnt(4)
    s_mov_b32 s60, 15360
    buffer_load_dwordx4 v[76:79], v252, s[32:35], s60 offen offset:0 nt
    s_waitcnt vmcnt(4)
    s_mov_b32 s60, 15360
    buffer_load_dwordx4 v[80:83], v252, s[32:35], s60 offen offset:128 nt
L_p1_join:
    v_lshlrev_b32 v9, 4, v1
    s_mul_i32 s61, s4, 2432
    s_mov_b32 exec_lo, 0xffffffff
    s_mov_b32 exec_hi, 0x1ffff
    buffer_load_dwordx4 v[240:243], v9, s[64:67], s61 offen offset:0 sc1
    buffer_load_dwordx4 v[244:247], v9, s[64:67], s61 offen offset:768 sc1
    buffer_load_dwordx4 v[248:251], v9, s[64:67], s61 offen offset:1536 sc1
    s_mov_b64 exec, -1
    s_waitcnt vmcnt(4)
    s_mov_b32 s60, 15360
    buffer_load_dwordx4 v[84:87], v252, s[32:35], s60 offen offset:256 nt
    s_waitcnt vmcnt(4)
    s_mov_b32 s60, 18432
    buffer_load_dwordx4 v[88:91], v252, s[32:35], s60 offen offset:0 nt
    s_waitcnt vmcnt(4)
    s_mov_b32 s60, 18432
    buffer_load_dwordx4 v[92:95], v252, s[32:35], s60 offen offset:128 nt
    s_waitcnt vmcnt(4)
    s_mov_b32 s60, 18432
    buffer_load_dwordx4 v[96:99], v252, s[32:35], s60 offen offset:256 nt
    s_waitcnt vmcnt(4)
    s_mov_b32 s60, 21504
    buffer_load_dwordx4 v[100:103], v252, s[32:35], s60 offen offset:0 nt
    s_waitcnt vmcnt(4)
    s_mov_b32 s60, 21504
    buffer_load_dwordx4 v[104:107], v252, s[32:35], s60 offen offset:128 nt
    s_waitcnt vmcnt(4)
    s_mov_b32 s60, 21504
    buffer_load_dwordx4 v[108:111], v252, s[32:35], s60 offen offset:256 nt
    s_mov_b32 s76, 0
    s_mov_b32 s63, 0
    s_branch L_e1_chk
L_e1_poll:
    s_xor_b32 s63, s63, 19456
    s_mul_i32 s61, s4, 2432
    s_add_u32 s61, s61, s63
    v_lshlrev_b32 v9, 4, v1
    s_mov_b32 exec_lo, 0xffffffff
    s_mov_b32 exec_hi, 0x1ffff
    buffer_load_dwordx4 v[240:243], v9, s[64:67], s61 offen offset:0 sc1
    buffer_load_dwordx4 v[244:247], v9, s[64:67], s61 offen offset:768 sc1
    buffer_load_dwordx4 v[248:251], v9, s[64:67], s61 offen offset:1536 sc1
    s_mov_b64 exec, -1
    s_waitcnt vmcnt(0)
L_e1_chk:
    s_mov_b32 exec_lo, 0xffffffff
    s_mov_b32 exec_hi, 0x1ffff
    v_xor_b32 v11, s50, v242
    v_xor_b32 v12, s51, v243
    v_or_b32 v10, v11, v12
    v_xor_b32 v11, s50, v246
    v_xor_b32 v12, s51, v247
    v_or3_b32 v10, v10, v11, v12
    v_xor_b32 v11, s50, v250
    v_xor_b32 v12, s51, v251
    v_or3_b32 v10, v10, v11, v12
    v_cmp_ne_u32 vcc, 0, v10
    s_mov_b64 exec, -1
    s_add_u32 s76, s76, 1
    s_cmp_ge_u32 s76, 2097152
    s_cbranch_scc1 L_e1_done
    s_cbranch_vccnz L_e1_poll
L_e1_done:
    s_mul_i32 s3, s4, 1152
    v_lshlrev_b32 v8, 3, v1
    v_add_u32 v8, s3, v8
    v_lshlrev_b32 v9, 2, v1
    v_add_u32 v9, s3, v9

    s_mov_b32 exec_lo, 0xffffffff
    s_mov_b32 exec_hi, 0xffff
    ds_write_b64 v8, v[240:241] offset:28672
    ds_write_b64 v8, v[244:245] offset:29056
    ds_write_b32 v9, v248 offset:29440
    ds_write_b32 v9, v249 offset:29632
    s_lshl_b32 s3, s4, 2
    s_mov_b32 exec_lo, 0
    s_mov_b32 exec_hi, 0x10000
    v_mov_b32 v9, s3
    ds_write_b32 v9, v248 offset:9792
    s_mov_b64 exec, -1
    s_waitcnt lgkmcnt(0)

    s_barrier
    s_cmp_gt_u32 s4, 2
    s_cbranch_scc1 L_fin_skip
    v_min_u32 v8, 47, v1
    s_cmp_eq_u32 s4, 2
    s_cbranch_scc1 L_fin_h
    s_mul_i32 s3, s4, 384
    v_lshlrev_b32 v12, 3, v8
    v_add_u32 v12, s3, v12
    v_mov_b32 v11, v8

    ds_read_b64 v[2:3], v12 offset:28672
    ds_read_b64 v[4:5], v12 offset:29824
    ds_read_b64 v[6:7], v12 offset:30976
    ds_read_b64 v[8:9], v12 offset:32128
    ds_read_b64 v[240:241], v12 offset:33280
    ds_read_b64 v[242:243], v12 offset:34432
    ds_read_b64 v[244:245], v12 offset:35584
    ds_read_b64 v[246:247], v12 offset:36736
    s_waitcnt lgkmcnt(0)
    v_add_f32 v2, v2, v4
    v_add_f32 v2, v2, v6
    v_add_f32 v2, v2, v8
    v_add_f32 v2, v2, v240
    v_add_f32 v2, v2, v242
    v_add_f32 v2, v2, v244
    v_add_f32 v2, v2, v246
    v_add_f32 v3, v3, v5
    v_add_f32 v3, v3, v7
    v_add_f32 v3, v3, v9
    v_add_f32 v3, v3, v241
    v_add_f32 v3, v3, v243
    v_add_f32 v3, v3, v245
    v_add_f32 v3, v3, v247
    v_cvt_pk_bf16_f32 v2, v2, v3
    s_mul_i32 s3, s4, 192
    v_lshlrev_b32 v8, 2, v11
    v_add_u32 v8, s3, v8
    ds_write_b32 v8, v2 offset:9216
    s_branch L_fin_skip
L_fin_h:
    v_lshlrev_b32 v12, 2, v8
    v_mov_b32 v248, v8

    ds_read_b32 v2, v12 offset:29440
    ds_read_b32 v6, v12 offset:29632
    ds_read_b32 v3, v12 offset:30592
    ds_read_b32 v7, v12 offset:30784
    ds_read_b32 v4, v12 offset:31744
    ds_read_b32 v8, v12 offset:31936
    ds_read_b32 v5, v12 offset:32896
    ds_read_b32 v9, v12 offset:33088
    ds_read_b32 v240, v12 offset:34048
    ds_read_b32 v244, v12 offset:34240
    ds_read_b32 v241, v12 offset:35200
    ds_read_b32 v245, v12 offset:35392
    ds_read_b32 v242, v12 offset:36352
    ds_read_b32 v246, v12 offset:36544
    ds_read_b32 v243, v12 offset:37504
    ds_read_b32 v247, v12 offset:37696
    s_waitcnt lgkmcnt(0)
    v_add_f32 v2, v2, v3
    v_add_f32 v6, v6, v7
    v_add_f32 v2, v2, v4
    v_add_f32 v6, v6, v8
    v_add_f32 v2, v2, v5
    v_add_f32 v6, v6, v9
    v_add_f32 v2, v2, v240
    v_add_f32 v6, v6, v244
    v_add_f32 v2, v2, v241
    v_add_f32 v6, v6, v245
    v_add_f32 v2, v2, v242
    v_add_f32 v6, v6, v246
    v_add_f32 v2, v2, v243
    v_add_f32 v6, v6, v247
    v_cvt_pk_bf16_f32 v2, v2, v2
    v_lshlrev_b32 v2, 16, v2
    v_cvt_pk_bf16_f32 v6, v6, v6
    v_lshlrev_b32 v6, 16, v6
    v_mul_f32 v10, v2, v2
    v_mul_f32 v10, v10, v2
    v_mov_b32 v11, v2
    v_fmac_f32 v11, 0x3d372713, v10
    v_mul_f32 v11, 0xc0135761, v11
    v_exp_f32 v11, v11
    s_nop 0
    v_add_f32 v11, 1.0, v11
    v_rcp_f32 v11, v11
    s_nop 0
    v_mul_f32 v11, v2, v11

    v_cvt_pk_bf16_f32 v11, v11, v11
    v_lshlrev_b32 v11, 16, v11
    v_mul_f32 v11, v11, v6
    v_cvt_pk_bf16_f32 v11, v11, v11
    v_lshlrev_b32 v9, 1, v248
    ds_write_b16 v9, v11 offset:9600
L_fin_skip:

    s_waitcnt lgkmcnt(0)
    s_barrier
    v_and_b32 v2, 7, v1
    v_lshlrev_b32 v2, 4, v2
    v_mov_b32 v244, 0
    v_mov_b32 v245, 0
    v_mov_b32 v246, 0
    v_mov_b32 v247, 0
    v_mov_b32 v248, 0
    v_mov_b32 v249, 0
    v_mov_b32 v250, 0
    v_mov_b32 v251, 0
    ds_read_b128 v[240:243], v2 offset:9216
    ds_read_b128 v[4:7], v2 offset:9344
    s_waitcnt vmcnt(0)
    s_waitcnt lgkmcnt(1)
    v_dot2c_f32_bf16 v244, v16, v240
    v_dot2c_f32_bf16 v245, v28, v240
    v_dot2c_f32_bf16 v246, v40, v240
    v_dot2c_f32_bf16 v247, v52, v240
    v_dot2c_f32_bf16 v248, v64, v240
    v_dot2c_f32_bf16 v249, v76, v240
    v_dot2c_f32_bf16 v250, v88, v240
    v_dot2c_f32_bf16 v251, v100, v240
    s_mov_b32 s60, 0
    buffer_load_dwordx4 v[112:115], v253, s[36:39], s60 offen nt
    v_dot2c_f32_bf16 v244, v17, v241
    v_dot2c_f32_bf16 v245, v29, v241
    v_dot2c_f32_bf16 v246, v41, v241
    v_dot2c_f32_bf16 v247, v53, v241
    v_dot2c_f32_bf16 v248, v65, v241
    v_dot2c_f32_bf16 v249, v77, v241
    v_dot2c_f32_bf16 v250, v89, v241
    v_dot2c_f32_bf16 v251, v101, v241
    s_mov_b32 s60, 0
    buffer_load_dwordx4 v[116:119], v253, s[36:39], s60 offen offset:384 nt
    v_dot2c_f32_bf16 v244, v18, v242
    v_dot2c_f32_bf16 v245, v30, v242
    v_dot2c_f32_bf16 v246, v42, v242
    v_dot2c_f32_bf16 v247, v54, v242
    v_dot2c_f32_bf16 v248, v66, v242
    v_dot2c_f32_bf16 v249, v78, v242
    v_dot2c_f32_bf16 v250, v90, v242
    v_dot2c_f32_bf16 v251, v102, v242
    s_mov_b32 s60, 0
    buffer_load_dwordx4 v[120:123], v252, s[36:39], s60 offen offset:256 nt
    v_dot2c_f32_bf16 v244, v19, v243
    v_dot2c_f32_bf16 v245, v31, v243
    v_dot2c_f32_bf16 v246, v43, v243
    v_dot2c_f32_bf16 v247, v55, v243
    v_dot2c_f32_bf16 v248, v67, v243
    v_dot2c_f32_bf16 v249, v79, v243
    v_dot2c_f32_bf16 v250, v91, v243
    v_dot2c_f32_bf16 v251, v103, v243
    s_mov_b32 s60, 3072
    buffer_load_dwordx4 v[124:127], v253, s[36:39], s60 offen nt
    s_waitcnt lgkmcnt(0)
    ds_read_b128 v[240:243], v2 offset:9472
    v_dot2c_f32_bf16 v244, v20, v4
    v_dot2c_f32_bf16 v245, v32, v4
    v_dot2c_f32_bf16 v246, v44, v4
    v_dot2c_f32_bf16 v247, v56, v4
    v_dot2c_f32_bf16 v248, v68, v4
    v_dot2c_f32_bf16 v249, v80, v4
    v_dot2c_f32_bf16 v250, v92, v4
    v_dot2c_f32_bf16 v251, v104, v4
    s_mov_b32 s60, 3072
    buffer_load_dwordx4 v[128:131], v253, s[36:39], s60 offen offset:384 nt
    v_dot2c_f32_bf16 v244, v21, v5
    v_dot2c_f32_bf16 v245, v33, v5
    v_dot2c_f32_bf16 v246, v45, v5
    v_dot2c_f32_bf16 v247, v57, v5
    v_dot2c_f32_bf16 v248, v69, v5
    v_dot2c_f32_bf16 v249, v81, v5
    v_dot2c_f32_bf16 v250, v93, v5
    v_dot2c_f32_bf16 v251, v105, v5
    s_waitcnt vmcnt(4)
    s_mov_b32 s60, 3072
    buffer_load_dwordx4 v[132:135], v252, s[36:39], s60 offen offset:256 nt
    v_dot2c_f32_bf16 v244, v22, v6
    v_dot2c_f32_bf16 v245, v34, v6
    v_dot2c_f32_bf16 v246, v46, v6
    v_dot2c_f32_bf16 v247, v58, v6
    v_dot2c_f32_bf16 v248, v70, v6
    v_dot2c_f32_bf16 v249, v82, v6
    v_dot2c_f32_bf16 v250, v94, v6
    v_dot2c_f32_bf16 v251, v106, v6
    s_waitcnt vmcnt(4)
    s_mov_b32 s60, 6144
    buffer_load_dwordx4 v[136:139], v253, s[36:39], s60 offen nt
    v_dot2c_f32_bf16 v244, v23, v7
    v_dot2c_f32_bf16 v245, v35, v7
    v_dot2c_f32_bf16 v246, v47, v7
    v_dot2c_f32_bf16 v247, v59, v7
    v_dot2c_f32_bf16 v248, v71, v7
    v_dot2c_f32_bf16 v249, v83, v7
    v_dot2c_f32_bf16 v250, v95, v7
    v_dot2c_f32_bf16 v251, v107, v7
    s_waitcnt vmcnt(4)
    s_mov_b32 s60, 6144
    buffer_load_dwordx4 v[140:143], v253, s[36:39], s60 offen offset:384 nt
    s_waitcnt lgkmcnt(0)
    v_dot2c_f32_bf16 v244, v24, v240
    v_dot2c_f32_bf16 v245, v36, v240
    v_dot2c_f32_bf16 v246, v48, v240
    v_dot2c_f32_bf16 v247, v60, v240
    v_dot2c_f32_bf16 v248, v72, v240
    v_dot2c_f32_bf16 v249, v84, v240
    v_dot2c_f32_bf16 v250, v96, v240
    v_dot2c_f32_bf16 v251, v108, v240
    s_waitcnt vmcnt(4)
    s_mov_b32 s60, 6144
    buffer_load_dwordx4 v[144:147], v252, s[36:39], s60 offen offset:256 nt
    v_dot2c_f32_bf16 v244, v25, v241
    v_dot2c_f32_bf16 v245, v37, v241
    v_dot2c_f32_bf16 v246, v49, v241
    v_dot2c_f32_bf16 v247, v61, v241
    v_dot2c_f32_bf16 v248, v73, v241
    v_dot2c_f32_bf16 v249, v85, v241
    v_dot2c_f32_bf16 v250, v97, v241
    v_dot2c_f32_bf16 v251, v109, v241
    s_waitcnt vmcnt(4)
    s_mov_b32 s60, 9216
    buffer_load_dwordx4 v[148:151], v253, s[36:39], s60 offen nt
    v_dot2c_f32_bf16 v244, v26, v242
    v_dot2c_f32_bf16 v245, v38, v242
    v_dot2c_f32_bf16 v246, v50, v242
    v_dot2c_f32_bf16 v247, v62, v242
    v_dot2c_f32_bf16 v248, v74, v242
    v_dot2c_f32_bf16 v249, v86, v242
    v_dot2c_f32_bf16 v250, v98, v242
    v_dot2c_f32_bf16 v251, v110, v242
    s_waitcnt vmcnt(4)
    s_mov_b32 s60, 9216
    buffer_load_dwordx4 v[152:155], v253, s[36:39], s60 offen offset:384 nt
    v_dot2c_f32_bf16 v244, v27, v243
    v_dot2c_f32_bf16 v245, v39, v243
    v_dot2c_f32_bf16 v246, v51, v243
    v_dot2c_f32_bf16 v247, v63, v243
    v_dot2c_f32_bf16 v248, v75, v243
    v_dot2c_f32_bf16 v249, v87, v243
    v_dot2c_f32_bf16 v250, v99, v243
    v_dot2c_f32_bf16 v251, v111, v243
    s_waitcnt vmcnt(4)
    s_mov_b32 s60, 9216
    buffer_load_dwordx4 v[156:159], v252, s[36:39], s60 offen offset:256 nt
    s_nop 1
    v_add_f32_dpp v244, v244, v244 quad_perm:[1,0,3,2] row_mask:0xf bank_mask:0xf
    v_add_f32_dpp v245, v245, v245 quad_perm:[1,0,3,2] row_mask:0xf bank_mask:0xf
    v_add_f32_dpp v246, v246, v246 quad_perm:[1,0,3,2] row_mask:0xf bank_mask:0xf
    v_add_f32_dpp v247, v247, v247 quad_perm:[1,0,3,2] row_mask:0xf bank_mask:0xf
    v_add_f32_dpp v248, v248, v248 quad_perm:[1,0,3,2] row_mask:0xf bank_mask:0xf
    v_add_f32_dpp v249, v249, v249 quad_perm:[1,0,3,2] row_mask:0xf bank_mask:0xf
    v_add_f32_dpp v250, v250, v250 quad_perm:[1,0,3,2] row_mask:0xf bank_mask:0xf
    v_add_f32_dpp v251, v251, v251 quad_perm:[1,0,3,2] row_mask:0xf bank_mask:0xf
    v_add_f32_dpp v244, v244, v244 quad_perm:[2,3,0,1] row_mask:0xf bank_mask:0xf
    v_add_f32_dpp v245, v245, v245 quad_perm:[2,3,0,1] row_mask:0xf bank_mask:0xf
    v_add_f32_dpp v246, v246, v246 quad_perm:[2,3,0,1] row_mask:0xf bank_mask:0xf
    v_add_f32_dpp v247, v247, v247 quad_perm:[2,3,0,1] row_mask:0xf bank_mask:0xf
    v_add_f32_dpp v248, v248, v248 quad_perm:[2,3,0,1] row_mask:0xf bank_mask:0xf
    v_add_f32_dpp v249, v249, v249 quad_perm:[2,3,0,1] row_mask:0xf bank_mask:0xf
    v_add_f32_dpp v250, v250, v250 quad_perm:[2,3,0,1] row_mask:0xf bank_mask:0xf
    v_add_f32_dpp v251, v251, v251 quad_perm:[2,3,0,1] row_mask:0xf bank_mask:0xf
    v_add_f32_dpp v244, v244, v244 row_half_mirror row_mask:0xf bank_mask:0xf
    v_add_f32_dpp v245, v245, v245 row_half_mirror row_mask:0xf bank_mask:0xf
    v_add_f32_dpp v246, v246, v246 row_half_mirror row_mask:0xf bank_mask:0xf
    v_add_f32_dpp v247, v247, v247 row_half_mirror row_mask:0xf bank_mask:0xf
    v_add_f32_dpp v248, v248, v248 row_half_mirror row_mask:0xf bank_mask:0xf
    v_add_f32_dpp v249, v249, v249 row_half_mirror row_mask:0xf bank_mask:0xf
    v_add_f32_dpp v250, v250, v250 row_half_mirror row_mask:0xf bank_mask:0xf
    v_add_f32_dpp v251, v251, v251 row_half_mirror row_mask:0xf bank_mask:0xf
    v_cvt_pk_bf16_f32 v244, v244, v244
    v_cvt_pk_bf16_f32 v245, v245, v245
    v_cvt_pk_bf16_f32 v246, v246, v246
    v_cvt_pk_bf16_f32 v247, v247, v247
    v_cvt_pk_bf16_f32 v248, v248, v248
    v_cvt_pk_bf16_f32 v249, v249, v249
    v_cvt_pk_bf16_f32 v250, v250, v250
    v_cvt_pk_bf16_f32 v251, v251, v251
    v_lshlrev_b32 v244, 16, v244
    v_lshlrev_b32 v245, 16, v245
    v_lshlrev_b32 v246, 16, v246
    v_lshlrev_b32 v247, 16, v247
    v_lshlrev_b32 v248, 16, v248
    v_lshlrev_b32 v249, 16, v249
    v_lshlrev_b32 v250, 16, v250
    v_lshlrev_b32 v251, 16, v251
    v_mul_f32 v244, 0x3d93cd3a, v244
    v_mul_f32 v245, 0x3d93cd3a, v245
    v_mul_f32 v246, 0x3d93cd3a, v246
    v_mul_f32 v247, 0x3d93cd3a, v247
    v_mul_f32 v248, 0x3d93cd3a, v248
    v_mul_f32 v249, 0x3d93cd3a, v249
    v_mul_f32 v250, 0x3d93cd3a, v250
    v_mul_f32 v251, 0x3d93cd3a, v251
    v_cvt_pk_bf16_f32 v244, v244, v244
    v_cvt_pk_bf16_f32 v245, v245, v245
    v_cvt_pk_bf16_f32 v246, v246, v246
    v_cvt_pk_bf16_f32 v247, v247, v247
    v_cvt_pk_bf16_f32 v248, v248, v248
    v_cvt_pk_bf16_f32 v249, v249, v249
    v_cvt_pk_bf16_f32 v250, v250, v250
    v_cvt_pk_bf16_f32 v251, v251, v251
    v_lshlrev_b32 v244, 16, v244
    v_lshlrev_b32 v245, 16, v245
    v_lshlrev_b32 v246, 16, v246
    v_lshlrev_b32 v247, 16, v247
    v_lshlrev_b32 v248, 16, v248
    v_lshlrev_b32 v249, 16, v249
    v_lshlrev_b32 v250, 16, v250
    v_lshlrev_b32 v251, 16, v251
    v_max3_f32 v2, v244, v245, v246
    v_max3_f32 v2, v2, v247, v248
    v_max3_f32 v2, v2, v249, v250
    v_max_f32 v2, v2, v251
    s_nop 1
    v_max_f32_dpp v2, v2, v2 row_ror:8 row_mask:0xf bank_mask:0xf
    s_nop 1
    v_readlane_b32 s84, v2, 0
    v_readlane_b32 s85, v2, 16
    v_readlane_b32 s86, v2, 32
    v_readlane_b32 s87, v2, 48
    s_nop 1
    v_mov_b32 v2, s84
    v_max_f32 v2, s85, v2
    v_max_f32 v2, s86, v2
    v_max_f32 v2, s87, v2
    v_mov_b32 v3, 0
    ds_read_b128 v[48:51], v3 offset:9792
    ds_read_b128 v[52:55], v3 offset:9808
    v_lshrrev_b32 v3, 4, v1
    s_mul_i32 s3, s4, 6
    v_add_u32 v12, s3, v3
    v_lshlrev_b32 v12, 1, v12
    ds_read_u16 v40, v12 offset:9600
    v_and_b32 v12, 1, v3
    v_add_u32 v12, s3, v12
    v_lshlrev_b32 v12, 1, v12
    ds_read_u16 v41, v12 offset:9608
    v_mul_f32 v45, 0x3fb8aa3b, v2
    s_mov_b32 s3, 0x3fb8aa3b

    v_fma_f32 v64, v244, s3, -v45
    v_fma_f32 v65, v245, s3, -v45
    v_fma_f32 v66, v246, s3, -v45
    v_fma_f32 v67, v247, s3, -v45
    v_fma_f32 v68, v248, s3, -v45
    v_fma_f32 v69, v249, s3, -v45
    v_fma_f32 v70, v250, s3, -v45
    v_fma_f32 v71, v251, s3, -v45
    v_exp_f32 v64, v64
    v_exp_f32 v65, v65
    v_exp_f32 v66, v66
    v_exp_f32 v67, v67
    v_exp_f32 v68, v68
    v_exp_f32 v69, v69
    v_exp_f32 v70, v70
    v_exp_f32 v71, v71
    v_cmp_gt_u32 vcc, 2, v3
    v_add_f32 v2, v64, v65
    v_add_f32 v2, v2, v66
    v_add_f32 v2, v2, v67
    v_add_f32 v2, v2, v68
    v_add_f32 v2, v2, v69
    v_add_f32 v2, v2, v70
    v_add_f32 v2, v2, v71
    s_nop 1
    v_add_f32_dpp v2, v2, v2 row_ror:8 row_mask:0xf bank_mask:0xf
    v_mov_b32 v4, v2
    s_nop 1
    v_permlane32_swap_b32 v2, v4
    s_nop 0
    v_add_f32 v2, v2, v4
    v_mov_b32 v4, v2
    s_nop 1
    v_permlane16_swap_b32 v2, v4
    s_nop 0
    v_add_f32 v2, v2, v4
    s_waitcnt lgkmcnt(0)
    v_cndmask_b32 v41, 0, v41, vcc
    v_xor_b32 v4, s77, v48

    v_xor_b32 v5, s77, v49
    v_or_b32 v4, v4, v5
    v_xor_b32 v5, s77, v50
    v_or_b32 v4, v4, v5
    v_xor_b32 v5, s77, v51
    v_or_b32 v4, v4, v5
    v_xor_b32 v5, s77, v52
    v_or_b32 v4, v4, v5
    v_xor_b32 v5, s77, v53
    v_or_b32 v4, v4, v5
    v_xor_b32 v5, s77, v54
    v_or_b32 v4, v4, v5
    v_xor_b32 v5, s77, v55
    v_or_b32 v4, v4, v5
    s_nop 0
    v_readfirstlane_b32 s78, v4
    v_mov_b32 v4, v45
    v_mov_b32 v5, v2
    v_mov_b32 v6, s50
    v_mov_b32 v7, s51
    s_lshl_b32 s3, s6, 3
    s_add_u32 s3, s3, s4
    s_lshl_b32 s3, s3, 4
    v_mov_b32 v8, 0
    s_mov_b64 exec, 1
    s_cmp_eq_u32 s78, 0
    s_cbranch_scc1 L_ml_fast
    buffer_store_dwordx4 v[4:7], v8, s[56:59], s3 offen sc1
    s_branch L_ml_stored
L_ml_fast:
    buffer_store_dwordx4 v[4:7], v8, s[56:59], s3 offen
L_ml_stored:
    s_mov_b64 exec, -1
    s_nop 1

    v_and_b32 v4, 7, v1
    v_and_b32 v5, 1, v1
    v_lshlrev_b32 v5, 4, v5
    v_mov_b32 v6, 0xffff
    v_lshlrev_b32 v6, v5, v6
    v_lshrrev_b32 v4, 1, v4

    v_cmp_eq_u32 vcc, 0, v4
    s_nop 1
    v_cndmask_b32 v16, 0, v6, vcc
    v_cmp_eq_u32 vcc, 1, v4
    s_nop 1
    v_cndmask_b32 v17, 0, v6, vcc
    v_cmp_eq_u32 vcc, 2, v4
    s_nop 1
    v_cndmask_b32 v18, 0, v6, vcc
    v_cmp_eq_u32 vcc, 3, v4
    s_nop 1
    v_cndmask_b32 v19, 0, v6, vcc
    v_mov_b32 v28, 0
    v_mov_b32 v29, 0
    v_mov_b32 v30, 0
    v_mov_b32 v31, 0
    v_mov_b32 v32, 0
    v_mov_b32 v33, 0
    v_mov_b32 v34, 0
    v_mov_b32 v35, 0
    v_mov_b32 v36, 0
    v_mov_b32 v37, 0
    v_mov_b32 v38, 0
    v_mov_b32 v39, 0
    v_lshrrev_b32 v3, 4, v1
    v_and_b32 v4, 7, v1
    v_bfe_u32 v5, v1, 3, 1
    s_lshl_b32 s3, s4, 1
    v_add_u32 v5, s3, v5
    v_mul_u32_u24 v5, 192, v5
    v_lshl_add_u32 v42, v3, 5, v5
    v_add_u32 v42, v42, v4
    v_lshlrev_b32 v42, 2, v42
    v_and_b32 v3, 1, v3
    v_lshl_add_u32 v43, v3, 5, v5
    v_add_u32 v43, v43, v4
    v_lshlrev_b32 v43, 2, v43
    v_lshrrev_b32 v3, 4, v1
    v_and_b32 v4, 15, v1
    v_lshl_add_u32 v44, v3, 5, v4
    s_mul_i32 s3, s4, 80
    v_add_u32 v44, s3, v44
    v_lshlrev_b32 v44, 2, v44
    v_lshl_or_b32 v40, v40, 16, v40
    v_lshl_or_b32 v41, v41, 16, v41

    v_and_b32 v2, 15, v1
    v_min_u32 v2, 11, v2
    v_lshrrev_b32 v3, 4, v1
    v_mul_u32_u24 v4, 3072, v3
    v_lshl_add_u32 v4, v2, 3, v4
    s_mul_i32 s3, s4, 96
    v_add_u32 v46, s3, v4
    s_mul_i32 s3, s4, 192
    v_lshlrev_b32 v8, 4, v2
    v_add_u32 v47, s3, v8
    v_mul_u32_u24 v9, 1536, v3
    v_add_u32 v60, v9, v47
    v_and_b32 v2, 1, v3
    v_mov_b32 v6, 0x01000100
    v_mov_b32 v7, 0x03020302
    v_cmp_eq_u32 vcc, 1, v2
    s_nop 1
    v_cndmask_b32 v61, v6, v7, vcc

    s_waitcnt vmcnt(4)
    s_mov_b32 s60, 12288
    buffer_load_dwordx4 v[160:163], v253, s[36:39], s60 offen nt
    s_waitcnt vmcnt(4)
    s_mov_b32 s60, 12288
    buffer_load_dwordx4 v[164:167], v253, s[36:39], s60 offen offset:384 nt
    s_waitcnt vmcnt(4)
    s_mov_b32 s60, 12288
    buffer_load_dwordx4 v[168:171], v252, s[36:39], s60 offen offset:256 nt
    s_waitcnt vmcnt(4)
    s_mov_b32 s60, 15360
    buffer_load_dwordx4 v[172:175], v253, s[36:39], s60 offen nt
    s_waitcnt vmcnt(4)
    s_mov_b32 s60, 15360
    buffer_load_dwordx4 v[176:179], v253, s[36:39], s60 offen offset:384 nt
    s_waitcnt vmcnt(4)
    s_mov_b32 s60, 15360
    buffer_load_dwordx4 v[180:183], v252, s[36:39], s60 offen offset:256 nt
    s_waitcnt vmcnt(4)
    s_mov_b32 s60, 18432
    buffer_load_dwordx4 v[184:187], v253, s[36:39], s60 offen nt
    s_waitcnt vmcnt(4)
    s_mov_b32 s60, 18432
    buffer_load_dwordx4 v[188:191], v253, s[36:39], s60 offen offset:384 nt
    s_waitcnt vmcnt(4)
    s_mov_b32 s60, 18432
    buffer_load_dwordx4 v[192:195], v252, s[36:39], s60 offen offset:256 nt
    s_waitcnt vmcnt(4)
    s_mov_b32 exec_lo, 0x3ff03ff
    s_mov_b32 exec_hi, 0x3ff03ff
    buffer_load_dwordx4 v[232:235], v254, s[44:47], 0 offen nt
    s_mov_b64 exec, -1
    v_lshlrev_b32 v9, 4, v1
    buffer_load_dwordx4 v[64:67], v9, s[56:59], 0 offen sc1
    s_waitcnt vmcnt(4)
    s_mov_b32 exec_lo, 0x3ff03ff
    s_mov_b32 exec_hi, 0x3ff03ff
    s_mov_b32 s60, 5120
    buffer_load_dwordx4 v[236:239], v255, s[44:47], s60 offen nt
    s_mov_b64 exec, -1
    s_waitcnt vmcnt(4)
    s_mov_b32 exec_lo, 0x3ff03ff
    s_mov_b32 exec_hi, 0x3ff03ff
    s_mov_b32 s60, 0
    buffer_load_dwordx4 v[208:211], v254, s[40:43], s60 offen nt
    s_mov_b64 exec, -1
    s_waitcnt vmcnt(4)
    s_mov_b32 exec_lo, 0x3ff03ff
    s_mov_b32 exec_hi, 0x3ff03ff
    s_mov_b32 s60, 5120
    buffer_load_dwordx4 v[212:215], v254, s[40:43], s60 offen nt
    s_mov_b64 exec, -1
    s_waitcnt vmcnt(4)
    s_mov_b32 exec_lo, 0x3ff03ff
    s_mov_b32 exec_hi, 0x3ff03ff
    s_mov_b32 s60, 10240
    buffer_load_dwordx4 v[216:219], v254, s[40:43], s60 offen nt
    s_mov_b64 exec, -1
    s_waitcnt vmcnt(4)
    s_mov_b32 exec_lo, 0x3ff03ff
    s_mov_b32 exec_hi, 0x3ff03ff
    s_mov_b32 s60, 15360
    buffer_load_dwordx4 v[220:223], v254, s[40:43], s60 offen nt
    s_mov_b64 exec, -1
    s_waitcnt vmcnt(4)
    s_mov_b32 s60, 21504
    buffer_load_dwordx4 v[196:199], v253, s[36:39], s60 offen nt
    s_waitcnt vmcnt(4)
    s_mov_b32 s60, 21504
    buffer_load_dwordx4 v[200:203], v253, s[36:39], s60 offen offset:384 nt
    s_waitcnt vmcnt(4)
    s_mov_b32 s60, 21504
    buffer_load_dwordx4 v[204:207], v252, s[36:39], s60 offen offset:256 nt
    s_mov_b32 s76, 0
    s_branch L_ml_chk
L_ml_poll:
    s_sleep 1
    v_lshlrev_b32 v9, 4, v1
    buffer_load_dwordx4 v[64:67], v9, s[56:59], 0 offen sc1
    s_waitcnt vmcnt(0)
L_ml_chk:
    v_xor_b32 v11, s50, v66
    v_xor_b32 v12, s51, v67
    v_or_b32 v10, v11, v12
    v_cmp_ne_u32 vcc, 0, v10
    s_add_u32 s76, s76, 1
    s_cmp_ge_u32 s76, 2097152
    s_cbranch_scc1 L_ml_poll_done
    s_cbranch_vccnz L_ml_poll
L_ml_poll_done:

    v_mov_b32 v2, v64
    s_nop 1
    v_max_f32_dpp v2, v2, v2 quad_perm:[1,0,3,2] row_mask:0xf bank_mask:0xf
    s_nop 1
    v_max_f32_dpp v2, v2, v2 quad_perm:[2,3,0,1] row_mask:0xf bank_mask:0xf
    s_nop 1
    v_max_f32_dpp v2, v2, v2 row_half_mirror row_mask:0xf bank_mask:0xf
    s_nop 1
    v_max_f32_dpp v2, v2, v2 row_mirror row_mask:0xf bank_mask:0xf
    v_mov_b32 v4, v2
    s_nop 1
    v_permlane32_swap_b32 v2, v4
    s_nop 0
    v_max_f32 v2, v2, v4
    v_mov_b32 v4, v2
    s_nop 1
    v_permlane16_swap_b32 v2, v4
    s_nop 0
    v_max_f32 v2, v2, v4
    v_sub_f32 v3, v64, v2
    v_exp_f32 v3, v3
    s_nop 0
    v_mul_f32 v3, v3, v65

    s_nop 1
    v_add_f32_dpp v3, v3, v3 quad_perm:[1,0,3,2] row_mask:0xf bank_mask:0xf
    s_nop 1
    v_add_f32_dpp v3, v3, v3 quad_perm:[2,3,0,1] row_mask:0xf bank_mask:0xf
    s_nop 1
    v_add_f32_dpp v3, v3, v3 row_half_mirror row_mask:0xf bank_mask:0xf
    s_nop 1
    v_add_f32_dpp v3, v3, v3 row_mirror row_mask:0xf bank_mask:0xf
    v_mov_b32 v4, v3
    s_nop 1
    v_permlane32_swap_b32 v3, v4
    s_nop 0
    v_add_f32 v3, v3, v4
    v_mov_b32 v4, v3
    s_nop 1
    v_permlane16_swap_b32 v3, v4
    s_nop 0
    v_add_f32 v3, v3, v4
    v_rcp_f32 v3, v3
    s_mov_b32 s3, 0x3fb8aa3b

    v_fma_f32 v244, v244, s3, -v2
    v_fma_f32 v245, v245, s3, -v2
    v_fma_f32 v246, v246, s3, -v2
    v_fma_f32 v247, v247, s3, -v2
    v_fma_f32 v248, v248, s3, -v2
    v_fma_f32 v249, v249, s3, -v2
    v_fma_f32 v250, v250, s3, -v2
    v_fma_f32 v251, v251, s3, -v2
    v_exp_f32 v244, v244
    v_exp_f32 v245, v245
    v_exp_f32 v246, v246
    v_exp_f32 v247, v247
    v_exp_f32 v248, v248
    v_exp_f32 v249, v249
    v_exp_f32 v250, v250
    v_exp_f32 v251, v251
    s_nop 0
    v_mul_f32 v244, v244, v3
    v_mul_f32 v245, v245, v3
    v_mul_f32 v246, v246, v3
    v_mul_f32 v247, v247, v3
    v_mul_f32 v248, v248, v3
    v_mul_f32 v249, v249, v3
    v_mul_f32 v250, v250, v3
    v_mul_f32 v251, v251, v3
    v_cvt_pk_bf16_f32 v244, v244, v244
    v_cvt_pk_bf16_f32 v245, v245, v245
    v_cvt_pk_bf16_f32 v246, v246, v246
    v_cvt_pk_bf16_f32 v247, v247, v247
    v_cvt_pk_bf16_f32 v248, v248, v248
    v_cvt_pk_bf16_f32 v249, v249, v249
    v_cvt_pk_bf16_f32 v250, v250, v250
    v_cvt_pk_bf16_f32 v251, v251, v251
    v_and_b32 v20, v244, v16
    v_and_b32 v21, v244, v17
    v_and_b32 v22, v244, v18
    v_and_b32 v23, v244, v19
    s_nop 1
    v_mfma_f32_16x16x32_bf16 v[28:31], v[112:115], v[20:23], v[28:31]
    v_mfma_f32_16x16x32_bf16 v[32:35], v[116:119], v[20:23], v[32:35]
    v_mfma_f32_16x16x32_bf16 v[36:39], v[120:123], v[20:23], v[36:39]
    v_and_b32 v24, v245, v16
    v_and_b32 v25, v245, v17
    v_and_b32 v26, v245, v18
    v_and_b32 v27, v245, v19
    s_nop 1
    v_mfma_f32_16x16x32_bf16 v[28:31], v[124:127], v[24:27], v[28:31]
    v_mfma_f32_16x16x32_bf16 v[32:35], v[128:131], v[24:27], v[32:35]
    v_mfma_f32_16x16x32_bf16 v[36:39], v[132:135], v[24:27], v[36:39]
    v_and_b32 v20, v246, v16
    v_and_b32 v21, v246, v17
    v_and_b32 v22, v246, v18
    v_and_b32 v23, v246, v19
    s_nop 1
    v_mfma_f32_16x16x32_bf16 v[28:31], v[136:139], v[20:23], v[28:31]
    v_mfma_f32_16x16x32_bf16 v[32:35], v[140:143], v[20:23], v[32:35]
    v_mfma_f32_16x16x32_bf16 v[36:39], v[144:147], v[20:23], v[36:39]
    v_and_b32 v24, v247, v16
    v_and_b32 v25, v247, v17
    v_and_b32 v26, v247, v18
    v_and_b32 v27, v247, v19
    s_nop 1
    v_mfma_f32_16x16x32_bf16 v[28:31], v[148:151], v[24:27], v[28:31]
    v_mfma_f32_16x16x32_bf16 v[32:35], v[152:155], v[24:27], v[32:35]
    v_mfma_f32_16x16x32_bf16 v[36:39], v[156:159], v[24:27], v[36:39]
    v_and_b32 v20, v248, v16
    v_and_b32 v21, v248, v17
    v_and_b32 v22, v248, v18
    v_and_b32 v23, v248, v19
    s_nop 1
    v_mfma_f32_16x16x32_bf16 v[28:31], v[160:163], v[20:23], v[28:31]
    v_mfma_f32_16x16x32_bf16 v[32:35], v[164:167], v[20:23], v[32:35]
    v_mfma_f32_16x16x32_bf16 v[36:39], v[168:171], v[20:23], v[36:39]
    v_and_b32 v24, v249, v16
    v_and_b32 v25, v249, v17
    v_and_b32 v26, v249, v18
    v_and_b32 v27, v249, v19
    s_nop 1
    v_mfma_f32_16x16x32_bf16 v[28:31], v[172:175], v[24:27], v[28:31]
    v_mfma_f32_16x16x32_bf16 v[32:35], v[176:179], v[24:27], v[32:35]
    v_mfma_f32_16x16x32_bf16 v[36:39], v[180:183], v[24:27], v[36:39]
    v_and_b32 v20, v250, v16
    v_and_b32 v21, v250, v17
    v_and_b32 v22, v250, v18
    v_and_b32 v23, v250, v19
    s_nop 1
    v_mfma_f32_16x16x32_bf16 v[28:31], v[184:187], v[20:23], v[28:31]
    v_mfma_f32_16x16x32_bf16 v[32:35], v[188:191], v[20:23], v[32:35]
    v_mfma_f32_16x16x32_bf16 v[36:39], v[192:195], v[20:23], v[36:39]
    v_and_b32 v24, v251, v16
    v_and_b32 v25, v251, v17
    v_and_b32 v26, v251, v18
    v_and_b32 v27, v251, v19
    s_waitcnt vmcnt(4)
    s_mov_b32 exec_lo, 0x3ff03ff
    s_mov_b32 exec_hi, 0x3ff03ff
    s_mov_b32 s60, 20480
    buffer_load_dwordx4 v[224:227], v254, s[40:43], s60 offen nt
    s_mov_b64 exec, -1
    s_waitcnt vmcnt(4)
    s_mov_b32 exec_lo, 0x3ff03ff
    s_mov_b32 exec_hi, 0x3ff03ff
    s_mov_b32 s60, 25600
    buffer_load_dwordx4 v[228:231], v254, s[40:43], s60 offen nt
    s_mov_b64 exec, -1
    s_waitcnt vmcnt(2)
    s_nop 1
    v_mfma_f32_16x16x32_bf16 v[28:31], v[196:199], v[24:27], v[28:31]
    v_mfma_f32_16x16x32_bf16 v[32:35], v[200:203], v[24:27], v[32:35]
    v_mfma_f32_16x16x32_bf16 v[36:39], v[204:207], v[24:27], v[36:39]
    v_and_b32 v8, 15, v1
    v_cmp_gt_u32 vcc, 8, v8
    s_mov_b32 exec_lo, 0xff00ff
    s_mov_b32 exec_hi, 0xff00ff00
    s_nop 4
    ds_write_b32 v43, v36 offset:10752
    ds_write_b32 v43, v37 offset:10784
    ds_write_b32 v43, v38 offset:10816
    ds_write_b32 v43, v39 offset:10848
    s_mov_b64 exec, -1
    v_cndmask_b32 v8, v32, v28, vcc
    v_cndmask_b32 v9, v33, v29, vcc
    v_cndmask_b32 v10, v34, v30, vcc
    v_cndmask_b32 v11, v35, v31, vcc
    ds_write_b32 v42, v8 offset:10240
    ds_write_b32 v42, v9 offset:10272
    ds_write_b32 v42, v10 offset:10304
    ds_write_b32 v42, v11 offset:10336
    s_waitcnt lgkmcnt(0)
    s_barrier
    ds_read_b64 v[112:113], v46 offset:10240
    ds_read_b64 v[114:115], v46 offset:11008
    ds_read_b64 v[116:117], v46 offset:11776
    ds_read_b64 v[118:119], v46 offset:12544
    v_mov_b32 v6, s50
    v_mov_b32 v7, s51
    s_mul_i32 s60, s6, 1536
    s_mov_b32 s61, 6144
    s_mov_b32 s76, 0
    s_waitcnt lgkmcnt(2)
    v_add_f32 v4, v112, v114
    v_add_f32 v5, v113, v115
    s_waitcnt lgkmcnt(0)
    v_add_f32 v8, v116, v118
    v_add_f32 v9, v117, v119
    v_add_f32 v4, v4, v8
    v_add_f32 v5, v5, v9

    v_mov_b32 v10, v4
    v_mov_b32 v11, v5
    s_nop 1
    v_permlane32_swap_b32 v4, v10
    v_permlane32_swap_b32 v5, v11
    v_add_f32 v4, v4, v10
    v_add_f32 v5, v5, v11
    v_mov_b32 v10, v4
    v_mov_b32 v11, v5
    s_nop 1
    v_permlane16_swap_b32 v4, v10
    v_permlane16_swap_b32 v5, v11
    v_add_f32 v4, v4, v10
    v_add_f32 v5, v5, v11
    s_mov_b32 exec_lo, 0xfff
    s_mov_b32 exec_hi, 0x0
    s_cmp_eq_u32 s78, 0
    s_cbranch_scc1 L_h1_fast
    buffer_store_dwordx4 v[4:7], v47, s[68:71], s60 offen sc1
    s_branch L_h1_stored
L_h1_fast:
    buffer_store_dwordx4 v[4:7], v47, s[68:71], s60 offen
L_h1_stored:
    s_mov_b64 exec, -1

    buffer_load_dwordx4 v[112:115], v60, s[68:71], 0 offen sc1
    buffer_load_dwordx4 v[116:119], v60, s[68:71], s61 offen sc1
    v_mov_b32 v48, 0
    v_mov_b32 v49, 0
    v_mov_b32 v50, 0
    v_mov_b32 v51, 0
    v_and_b32 v52, v40, v16
    v_and_b32 v53, v40, v17
    v_and_b32 v54, v40, v18
    v_and_b32 v55, v40, v19
    v_and_b32 v56, v41, v16
    v_and_b32 v57, v41, v17
    v_and_b32 v58, v41, v18
    v_and_b32 v59, v41, v19
    s_waitcnt vmcnt(5)
    s_nop 0
    v_mfma_f32_16x16x32_bf16 v[48:51], v[232:235], v[52:55], v[48:51]
    v_mfma_f32_16x16x32_bf16 v[48:51], v[236:239], v[56:59], v[48:51]
    s_mov_b32 exec_lo, 0xff00ff
    s_mov_b32 exec_hi, 0xff
    s_nop 5
    ds_write_b32 v44, v48 offset:25600
    ds_write_b32 v44, v49 offset:25632
    s_mov_b32 exec_lo, 0xff00ff
    s_mov_b32 exec_hi, 0x0
    ds_write_b32 v44, v50 offset:25664
    ds_write_b32 v44, v51 offset:25696
    s_mov_b64 exec, -1
    v_mov_b32 v28, 0
    v_mov_b32 v29, 0
    v_mov_b32 v30, 0
    v_mov_b32 v31, 0
    s_branch L_h1_wait
L_h1_poll:
    s_sleep 1
    buffer_load_dwordx4 v[112:115], v60, s[68:71], 0 offen sc1
    buffer_load_dwordx4 v[116:119], v60, s[68:71], s61 offen sc1
L_h1_wait:
    s_waitcnt vmcnt(0)
    v_xor_b32 v11, s50, v114
    v_xor_b32 v12, s51, v115
    v_or_b32 v10, v11, v12
    v_xor_b32 v11, s50, v118
    v_xor_b32 v12, s51, v119
    v_or3_b32 v10, v10, v11, v12
    v_cmp_ne_u32 vcc, 0, v10
    s_add_u32 s76, s76, 1
    s_cmp_ge_u32 s76, 2097152
    s_cbranch_scc1 L_h1_poll_done
    s_cbranch_vccnz L_h1_poll
L_h1_poll_done:

    v_add_f32 v8, v112, v116
    v_add_f32 v9, v113, v117
    v_mov_b32 v10, v8
    v_mov_b32 v11, v9
    s_nop 1
    v_permlane32_swap_b32 v8, v10
    v_permlane32_swap_b32 v9, v11
    v_add_f32 v8, v8, v10
    v_add_f32 v9, v9, v11
    v_mov_b32 v10, v8
    v_mov_b32 v11, v9
    s_nop 1
    v_permlane16_swap_b32 v8, v10
    v_permlane16_swap_b32 v9, v11
    v_add_f32 v8, v8, v10
    v_add_f32 v9, v9, v11
    v_cvt_pk_bf16_f32 v8, v8, v9
    s_nop 1
    v_mov_b32_dpp v2, v8 row_newbcast:0 row_mask:0x3 bank_mask:0xf
    v_mov_b32_dpp v2, v8 row_newbcast:1 row_mask:0xc bank_mask:0xf
    v_perm_b32 v2, v2, v2, v61
    v_and_b32 v136, v2, v16
    v_and_b32 v137, v2, v17
    v_and_b32 v138, v2, v18
    v_and_b32 v139, v2, v19
    v_mov_b32_dpp v3, v8 row_newbcast:2 row_mask:0x3 bank_mask:0xf
    v_mov_b32_dpp v3, v8 row_newbcast:3 row_mask:0xc bank_mask:0xf
    v_perm_b32 v3, v3, v3, v61
    v_and_b32 v140, v3, v16
    v_and_b32 v141, v3, v17
    v_and_b32 v142, v3, v18
    v_and_b32 v143, v3, v19
    v_mfma_f32_16x16x32_bf16 v[28:31], v[208:211], v[136:139], v[28:31]
    v_mov_b32_dpp v2, v8 row_newbcast:4 row_mask:0x3 bank_mask:0xf
    v_mov_b32_dpp v2, v8 row_newbcast:5 row_mask:0xc bank_mask:0xf
    v_perm_b32 v2, v2, v2, v61
    v_and_b32 v144, v2, v16
    v_and_b32 v145, v2, v17
    v_and_b32 v146, v2, v18
    v_and_b32 v147, v2, v19
    v_mfma_f32_16x16x32_bf16 v[28:31], v[212:215], v[140:143], v[28:31]
    v_mov_b32_dpp v3, v8 row_newbcast:6 row_mask:0x3 bank_mask:0xf
    v_mov_b32_dpp v3, v8 row_newbcast:7 row_mask:0xc bank_mask:0xf
    v_perm_b32 v3, v3, v3, v61
    v_and_b32 v148, v3, v16
    v_and_b32 v149, v3, v17
    v_and_b32 v150, v3, v18
    v_and_b32 v151, v3, v19
    v_mfma_f32_16x16x32_bf16 v[28:31], v[216:219], v[144:147], v[28:31]
    v_mov_b32_dpp v2, v8 row_newbcast:8 row_mask:0x3 bank_mask:0xf
    v_mov_b32_dpp v2, v8 row_newbcast:9 row_mask:0xc bank_mask:0xf
    v_perm_b32 v2, v2, v2, v61
    v_and_b32 v152, v2, v16
    v_and_b32 v153, v2, v17
    v_and_b32 v154, v2, v18
    v_and_b32 v155, v2, v19
    v_mfma_f32_16x16x32_bf16 v[28:31], v[220:223], v[148:151], v[28:31]
    v_mov_b32_dpp v3, v8 row_newbcast:10 row_mask:0x3 bank_mask:0xf
    v_mov_b32_dpp v3, v8 row_newbcast:11 row_mask:0xc bank_mask:0xf
    v_perm_b32 v3, v3, v3, v61
    v_and_b32 v156, v3, v16
    v_and_b32 v157, v3, v17
    v_and_b32 v158, v3, v18
    v_and_b32 v159, v3, v19
    v_mfma_f32_16x16x32_bf16 v[28:31], v[224:227], v[152:155], v[28:31]
    s_nop 1
    v_mfma_f32_16x16x32_bf16 v[28:31], v[228:231], v[156:159], v[28:31]
    s_mov_b32 exec_lo, 0xff00ff
    s_mov_b32 exec_hi, 0xff
    s_nop 5
    ds_write_b32 v44, v28 offset:23040
    ds_write_b32 v44, v29 offset:23072
    s_mov_b32 exec_lo, 0xff00ff
    s_mov_b32 exec_hi, 0x0
    ds_write_b32 v44, v30 offset:23104
    ds_write_b32 v44, v31 offset:23136
    s_mov_b64 exec, -1
    s_waitcnt lgkmcnt(0)
    s_barrier
    s_cmp_gt_u32 s4, 1
    s_cbranch_scc1 L_h2_pub_skip
    s_lshl_b32 s3, s4, 6
    v_add_u32 v2, s3, v1
    v_min_u32 v3, 79, v2
    v_lshlrev_b32 v3, 2, v3

    ds_read_b32 v112, v3 offset:23040
    ds_read_b32 v113, v3 offset:25600
    ds_read_b32 v114, v3 offset:23360
    ds_read_b32 v115, v3 offset:25920
    ds_read_b32 v116, v3 offset:23680
    ds_read_b32 v117, v3 offset:26240
    ds_read_b32 v118, v3 offset:24000
    ds_read_b32 v119, v3 offset:26560
    ds_read_b32 v120, v3 offset:24320
    ds_read_b32 v121, v3 offset:26880
    ds_read_b32 v122, v3 offset:24640
    ds_read_b32 v123, v3 offset:27200
    ds_read_b32 v124, v3 offset:24960
    ds_read_b32 v125, v3 offset:27520
    ds_read_b32 v126, v3 offset:25280
    ds_read_b32 v127, v3 offset:27840
    v_mov_b32 v6, s50
    v_mov_b32 v7, s51
    v_lshrrev_b32 v8, 1, v2
    v_lshlrev_b32 v8, 10, v8
    v_and_b32 v9, 1, v2
    v_lshl_add_u32 v8, v9, 4, v8
    s_mul_i32 s60, s6, 40960
    s_lshl_b32 s3, s5, 5
    s_add_u32 s60, s60, s3
    v_cmp_gt_u32 vcc, 80, v2
    s_waitcnt lgkmcnt(0)

    v_add_f32 v4, v112, v114
    v_add_f32 v4, v4, v116
    v_add_f32 v4, v4, v118
    v_add_f32 v4, v4, v120
    v_add_f32 v4, v4, v122
    v_add_f32 v4, v4, v124
    v_add_f32 v4, v4, v126
    v_add_f32 v5, v113, v115
    v_add_f32 v5, v5, v117
    v_add_f32 v5, v5, v119
    v_add_f32 v5, v5, v121
    v_add_f32 v5, v5, v123
    v_add_f32 v5, v5, v125
    v_add_f32 v5, v5, v127
    s_and_saveexec_b64 s[90:91], vcc
    buffer_store_dwordx4 v[4:7], v8, s[72:75], s60 offen sc1
    s_mov_b64 exec, -1
L_h2_pub_skip:

    s_cmp_ge_u32 s5, 5
    s_cbranch_scc1 L_exit
    s_lshl_b32 s3, s5, 3
    s_add_u32 s3, s3, s4
    s_mul_i32 s61, s6, 80
    s_lshl_b32 s62, s3, 1
    s_add_u32 s61, s61, s62
    v_and_b32 v2, 1, v1
    v_add_u32 v3, s61, v2
    v_lshlrev_b32 v3, 1, v3
    global_load_ushort v9, v3, s[8:9]
    v_lshlrev_b32 v4, 4, v1
    s_mul_i32 s60, s6, 40960
    s_lshl_b32 s3, s3, 10
    s_add_u32 s60, s60, s3
    s_mov_b32 s76, 0
    s_branch L_h2_first
L_h2_poll:
    s_sleep 1
L_h2_first:
    buffer_load_dwordx4 v[112:115], v4, s[72:75], s60 offen sc1
    s_waitcnt vmcnt(0)

    v_xor_b32 v11, s50, v114
    v_xor_b32 v12, s51, v115
    v_or_b32 v10, v11, v12
    v_cmp_ne_u32 vcc, 0, v10
    s_add_u32 s76, s76, 1
    s_cmp_ge_u32 s76, 2097152
    s_cbranch_scc1 L_h2_poll_done
    s_cbranch_vccnz L_h2_poll
L_h2_poll_done:

    s_nop 0
    v_add_f32_dpp v112, v112, v112 quad_perm:[2,3,0,1] row_mask:0xf bank_mask:0xf
    v_add_f32_dpp v113, v113, v113 quad_perm:[2,3,0,1] row_mask:0xf bank_mask:0xf
    s_nop 0
    v_add_f32_dpp v112, v112, v112 row_ror:4 row_mask:0xf bank_mask:0xf
    v_add_f32_dpp v113, v113, v113 row_ror:4 row_mask:0xf bank_mask:0xf
    s_nop 0
    v_add_f32_dpp v112, v112, v112 row_ror:8 row_mask:0xf bank_mask:0xf
    v_add_f32_dpp v113, v113, v113 row_ror:8 row_mask:0xf bank_mask:0xf
    v_mov_b32 v10, v112
    v_mov_b32 v11, v113
    s_nop 1
    v_permlane32_swap_b32 v112, v10
    v_permlane32_swap_b32 v113, v11
    v_add_f32 v112, v112, v10
    v_add_f32 v113, v113, v11
    v_mov_b32 v10, v112
    v_mov_b32 v11, v113
    s_nop 1
    v_permlane16_swap_b32 v112, v10
    v_permlane16_swap_b32 v113, v11
    v_add_f32 v112, v112, v10
    v_add_f32 v113, v113, v11
    v_cvt_pk_bf16_f32 v112, v112, v112
    v_lshlrev_b32 v112, 16, v112
    v_cvt_pk_bf16_f32 v113, v113, v113
    v_lshlrev_b32 v113, 16, v113
    v_mul_f32 v5, 0xbfb8aa3b, v113
    v_exp_f32 v5, v5
    s_nop 0
    v_add_f32 v5, 1.0, v5
    v_rcp_f32 v5, v5
    s_nop 0
    v_mul_f32 v5, v113, v5

    v_cvt_pk_bf16_f32 v5, v5, v5
    v_lshlrev_b32 v5, 16, v5
    v_mul_f32 v5, v112, v5
    v_cvt_pk_bf16_f32 v5, v5, v5
    v_lshlrev_b32 v5, 16, v5
    v_lshlrev_b32 v9, 16, v9
    v_add_f32 v5, v9, v5
    v_cvt_pk_bf16_f32 v5, v5, v5

    s_mov_b32 exec_lo, 0x3
    s_mov_b32 exec_hi, 0x0
    global_store_short v3, v5, s[26:27]
    s_cmp_lg_u32 s7, 0
    s_cbranch_scc1 L_exit
    s_cmp_lg_u32 s4, 0
    s_cbranch_scc1 L_exit
    s_mov_b64 exec, 1
    v_mov_b32 v6, s48
    v_mov_b32 v7, s49
    v_mov_b32 v8, 0
    global_store_dwordx2 v8, v[6:7], s[30:31] sc1

L_exit:
L_end:
    s_endpgm
.section .rodata,"a"
.p2align 6
.amdhsa_kernel recurrent_scan__sliding_block_cached__geglu_ffn__decode_kernel
  .amdhsa_next_free_vgpr 256
  .amdhsa_next_free_sgpr 102
  .amdhsa_accum_offset 256
  .amdhsa_group_segment_fixed_size 0
  .amdhsa_kernarg_size 96
  .amdhsa_user_sgpr_count 2
  .amdhsa_user_sgpr_kernarg_segment_ptr 1
  .amdhsa_system_sgpr_workgroup_id_x 1
.end_amdhsa_kernel
```
